```python
import torch

def _softmax(x, axis=-1):
    return torch.softmax(x, dim=axis)
def _gelu(x):
    return torch.nn.functional.gelu(x, approximate="tanh")
def _silu(x):
    return torch.nn.functional.silu(x)
def _sigmoid(x):
    return torch.sigmoid(x)
def _layernorm(x, axis=-1, eps=1e-5):
    m = x.mean(dim=axis, keepdim=True)
    v = x.var(dim=axis, keepdim=True, unbiased=False)
    return (x - m) / torch.sqrt(v + eps)
def _scatter_add(tgt, idx, src, axis=0):
    return tgt.clone().index_add_(axis, idx, src)
def _segment_sum(src, seg, n):
    out = torch.zeros((n,) + src.shape[1:], dtype=src.dtype)
    return out.index_add_(0, seg, src)
def _pad(x, pw):
    flat = tuple(v for pair in reversed(pw) for v in pair)
    return torch.nn.functional.pad(x, flat)

kernel_name = 'standalone__ragged_sequences_packed_sequences__ragged'

def setup_inputs():

    _w = (lambda a: (lambda t: t.to(torch.bfloat16) if t.is_floating_point() else t)(torch.as_tensor(a)))
    cu = torch.tensor([0, 400, 516, 964, 1456, 1702, 1900, 2021, 2266], dtype=torch.int64)
    T = int(cu[-1])
    H, D = 16, 128
    lens = torch.diff(cu)
    seg_ids = torch.repeat_interleave(torch.arange(len(lens), dtype=torch.int64), lens)
    return {
        "q": _w((lambda *s: torch.randn(*s, dtype=torch.bfloat16) * 0.8)(T, H, D)),
        "k": _w((lambda *s: torch.randn(*s, dtype=torch.bfloat16) * 0.8)(T, H, D)),
        "v": _w((lambda *s: torch.randn(*s, dtype=torch.bfloat16) * 0.05)(T, H, D)),
        "seg_ids": _w(seg_ids),
    }

def reference(q, k, v, seg_ids):
    T, H, D = q.shape
    scale = D ** -0.5
    same_seq = seg_ids[:, None] == seg_ids[None, :]
    logits = torch.einsum("qhd,khd->hqk", q, k) * scale
    bias = (1.0 - (lambda x, dt: x.to(dt))(same_seq, q.dtype)) * (-1e9)
    p = _softmax(logits + bias[None, :, :], axis=-1)
    return torch.einsum("hqk,khd->qhd", p, v)
```

```asm
; @launch grid=(256,1,1) block=(512,1,1) lds=156672
.amdgcn_target "amdgcn-amd-amdhsa--gfx950"
.text
.globl standalone__ragged_sequences_packed_sequences__ragged_kernel
.p2align 8
.type standalone__ragged_sequences_packed_sequences__ragged_kernel,@function
standalone__ragged_sequences_packed_sequences__ragged_kernel:
    s_cmp_ge_u32 s2, 256
    s_cbranch_scc1 L_end
    s_load_dwordx4 s[24:27], s[0:1], 0
    s_load_dwordx2 s[28:29], s[0:1], 16
    s_load_dwordx2 s[30:31], s[0:1], 32
    v_lshrrev_b32 v1, 6, v0
    s_and_b32 s4, s2, 7
    v_readfirstlane_b32 s3, v1
    s_lshl_b32 s4, s4, 1
    s_bfe_u32 s5, s2, 0x10003
    s_or_b32 s4, s4, s5
    s_lshr_b32 s5, s2, 4
    s_lshr_b32 s6, s3, 2
    s_and_b32 s7, s3, 3
    s_lshl_b32 s5, s5, 1
    s_add_u32 s5, s5, s6
    s_lshl_b32 s5, s5, 4
    s_getpc_b64 s[32:33]
L_pc:
    s_add_u32 s80, s32, L_rare-L_pc
    s_addc_u32 s81, s33, 0
    s_add_u32 s32, s32, L_table-L_pc
    s_addc_u32 s33, s33, 0
    s_load_dwordx4 s[36:39], s[32:33], s5
    v_and_b32 v0, 63, v0
    s_lshl_b32 s34, s4, 8
    v_lshrrev_b32 v16, 4, v0
    v_and_b32 v17, 15, v0
    s_lshl_b32 s35, s7, 14
    s_add_u32 s35, s35, s34
    v_xor_b32 v18, v17, v16
    v_lshlrev_b32 v18, 4, v18
    v_lshl_add_u32 v22, v16, 12, v18
    v_add_u32 v1, s35, v22
    v_add_u32 v3, 0x10000, v1
    s_lshl_b32 s35, s7, 12
    s_add_u32 s35, s35, s34
    v_lshlrev_b32 v18, 4, v17
    v_lshl_add_u32 v18, v16, 14, v18
    v_add_u32 v2, s35, v18
    v_add_u32 v4, 0x10000, v2
    s_mul_i32 s55, s6, 69632
    s_mul_i32 s35, s7, 1088
    s_add_u32 s52, s55, s35
    s_add_u32 s53, s52, 34816
    s_add_u32 s67, s52, 4352
    s_add_u32 s68, s53, 4352
    s_mov_b32 s64, 0
    s_mov_b32 s65, 17408
    s_mov_b32 s66, 26112
    s_add_u32 s33, s7, 4
    s_cmp_eq_u32 s7, 1
    s_cselect_b32 s33, 3, s33
    s_mul_i32 s59, s33, 8704
    v_and_b32 v16, 31, v0
    v_lshrrev_b32 v17, 5, v0
    s_lshl_b32 s35, s7, 5
    s_waitcnt lgkmcnt(0)
    s_add_u32 s33, s36, s37
    s_lshl_b32 s33, s33, 12
    s_mov_b32 s12, s26
    s_and_b32 s13, s27, 0xffff
    s_mov_b32 s14, s33
    s_mov_b32 s15, 0x00020000
    s_lshl_b32 s50, s36, 12
    s_add_u32 m0, s52, 0
    s_nop 0
    buffer_load_dwordx4 v1, s[12:15], s50 offen lds
    s_add_u32 m0, s52, 4352
    s_nop 0
    buffer_load_dwordx4 v3, s[12:15], s50 offen lds
    s_add_u32 s50, s50, 0x20000
    s_mov_b32 s8, s24
    s_and_b32 s9, s25, 0xffff
    s_mov_b32 s10, 9281536
    s_mov_b32 s11, 0x00020000
    s_add_u32 s49, s38, s35
    s_bfe_u32 s47, s39, 0x10010
    s_cmp_eq_u32 s47, 0
    s_cselect_b32 s60, s6, 0
    s_cselect_b32 s61, 0, s6
    s_mul_i32 s35, s60, 8704
    s_add_u32 s35, s35, 139264
    s_mul_i32 s60, s60, 69632
    s_add_u32 s60, s60, s59
    s_cmp_eq_u32 s7, 0
    s_cselect_b32 s58, s35, s60
    s_lshl_b32 s35, s49, 12
    s_add_u32 s35, s35, s34
    v_add_u32 v22, s35, v22
    s_lshl_b32 s35, s61, 16
    s_mul_i32 s61, s61, 4352
    s_add_u32 s61, s61, s58
    s_add_u32 m0, s61, 0
    s_nop 0
    buffer_load_dwordx4 v22, s[8:11], s35 offen nt lds
    s_add_u32 s35, s35, 0x4000
    s_add_u32 m0, s61, 1088
    s_nop 0
    buffer_load_dwordx4 v22, s[8:11], s35 offen nt lds
    s_add_u32 s35, s35, 0x4000
    s_add_u32 m0, s61, 2176
    s_nop 0
    buffer_load_dwordx4 v22, s[8:11], s35 offen nt lds
    s_add_u32 s35, s35, 0x4000
    s_add_u32 m0, s61, 3264
    s_nop 0
    buffer_load_dwordx4 v22, s[8:11], s35 offen nt lds
    s_add_u32 s35, s35, 0x4000
    s_cmp_lg_u32 s47, 0
    s_cbranch_scc1 L_qdone
    s_add_u32 m0, s61, 4352
    s_nop 0
    buffer_load_dwordx4 v22, s[8:11], s35 offen nt lds
    s_add_u32 s35, s35, 0x4000
    s_add_u32 m0, s61, 5440
    s_nop 0
    buffer_load_dwordx4 v22, s[8:11], s35 offen nt lds
    s_add_u32 s35, s35, 0x4000
    s_add_u32 m0, s61, 6528
    s_nop 0
    buffer_load_dwordx4 v22, s[8:11], s35 offen nt lds
    s_add_u32 s35, s35, 0x4000
    s_add_u32 m0, s61, 7616
    s_nop 0
    buffer_load_dwordx4 v22, s[8:11], s35 offen nt lds
L_qdone:
    s_add_u32 m0, s52, 8704
    s_nop 0
    buffer_load_dwordx4 v1, s[12:15], s50 offen lds
    s_add_u32 m0, s52, 13056
    s_nop 0
    buffer_load_dwordx4 v3, s[12:15], s50 offen lds
    s_add_u32 s50, s50, 0x20000
    s_mov_b32 s16, s28
    s_and_b32 s17, s29, 0xffff
    s_mov_b32 s18, s33
    s_mov_b32 s19, 0x00020000
    s_lshl_b32 s51, s36, 12
    s_add_u32 m0, s53, 0
    s_nop 0
    buffer_load_dwordx4 v2, s[16:19], s51 offen lds
    s_add_u32 m0, s53, 4352
    s_nop 0
    buffer_load_dwordx4 v4, s[16:19], s51 offen lds
    s_add_u32 s51, s51, 0x20000
    s_add_u32 m0, s52, 17408
    s_nop 0
    buffer_load_dwordx4 v1, s[12:15], s50 offen lds
    s_add_u32 m0, s52, 21760
    s_nop 0
    buffer_load_dwordx4 v3, s[12:15], s50 offen lds
    s_add_u32 s50, s50, 0x20000
    s_add_u32 m0, s53, 8704
    s_nop 0
    buffer_load_dwordx4 v2, s[16:19], s51 offen lds
    s_add_u32 m0, s53, 13056
    s_nop 0
    buffer_load_dwordx4 v4, s[16:19], s51 offen lds
    s_add_u32 s51, s51, 0x20000
    s_mov_b32 s20, s30
    s_and_b32 s21, s31, 0xffff
    s_and_b32 s48, s39, 0xffff
    s_lshl_b32 s22, s48, 12
    s_mov_b32 s23, 0x00020000
    v_lshlrev_b32 v14, 2, v17
    v_lshrrev_b32 v20, 2, v16
    v_and_b32 v21, 3, v16
    v_mul_u32_u24 v20, 1088, v20
    v_lshl_add_u32 v20, v21, 8, v20
    v_xor_b32 v21, v21, v17
    v_lshlrev_b32 v21, 4, v21
    v_add_u32 v22, v20, v21
    v_xor_b32 v21, 32, v21
    v_add_u32 v23, v20, v21
    v_add_u32 v5, s55, v22
    v_add_u32 v6, s55, v23
    v_add_u32 v22, s58, v22
    v_add_u32 v23, s58, v23
    v_bfe_u32 v20, v0, 2, 2
    v_mul_u32_u24 v20, 1088, v20
    v_lshl_add_u32 v20, v17, 8, v20
    v_bfe_u32 v21, v0, 4, 1
    v_lshl_add_u32 v20, v21, 5, v20
    v_and_b32 v21, 3, v0
    v_lshl_add_u32 v20, v21, 3, v20
    s_lshl_b32 s56, s6, 7
    s_xor_b32 s57, s56, 128
    s_add_u32 s35, s55, 34816
    v_add_u32 v20, s35, v20
    v_add_u32 v7, s56, v20
    v_add_u32 v8, s57, v20
    s_mov_b32 s40, 0x3e0293ee
    s_mov_b32 s41, s40
    s_mov_b32 s42, 0x43800000
    s_mov_b32 s63, 0x3f803f80
    s_add_u32 s44, s37, 31
    s_lshr_b32 s44, s44, 5
    s_lshr_b32 s45, s39, 20
    s_sub_u32 s46, s44, 2
    s_sub_u32 s35, s44, 1
    s_lshl_b32 s35, s35, 5
    s_sub_u32 s54, s37, s35
    s_mov_b32 s43, 0
    s_sub_u32 s35, s54, 1
    v_sub_u32 v20, s35, v14
    v_subrev_u32 v240, 0, v20
    v_subrev_u32 v241, 1, v20
    v_subrev_u32 v242, 2, v20
    v_subrev_u32 v243, 3, v20
    v_subrev_u32 v244, 8, v20
    v_subrev_u32 v245, 9, v20
    v_subrev_u32 v246, 10, v20
    v_subrev_u32 v247, 11, v20
    v_subrev_u32 v248, 16, v20
    v_subrev_u32 v249, 17, v20
    v_subrev_u32 v250, 18, v20
    v_subrev_u32 v251, 19, v20
    v_subrev_u32 v252, 24, v20
    v_subrev_u32 v253, 25, v20
    v_subrev_u32 v254, 26, v20
    v_subrev_u32 v255, 27, v20
    v_ashrrev_i32 v240, 31, v240
    v_ashrrev_i32 v241, 31, v241
    v_ashrrev_i32 v242, 31, v242
    v_ashrrev_i32 v243, 31, v243
    v_ashrrev_i32 v244, 31, v244
    v_ashrrev_i32 v245, 31, v245
    v_ashrrev_i32 v246, 31, v246
    v_ashrrev_i32 v247, 31, v247
    v_ashrrev_i32 v248, 31, v248
    v_ashrrev_i32 v249, 31, v249
    v_ashrrev_i32 v250, 31, v250
    v_ashrrev_i32 v251, 31, v251
    v_ashrrev_i32 v252, 31, v252
    v_ashrrev_i32 v253, 31, v253
    v_ashrrev_i32 v254, 31, v254
    v_ashrrev_i32 v255, 31, v255
    v_lshlrev_b32 v240, 23, v240
    v_lshlrev_b32 v241, 23, v241
    v_lshlrev_b32 v242, 23, v242
    v_lshlrev_b32 v243, 23, v243
    v_lshlrev_b32 v244, 23, v244
    v_lshlrev_b32 v245, 23, v245
    v_lshlrev_b32 v246, 23, v246
    v_lshlrev_b32 v247, 23, v247
    v_lshlrev_b32 v248, 23, v248
    v_lshlrev_b32 v249, 23, v249
    v_lshlrev_b32 v250, 23, v250
    v_lshlrev_b32 v251, 23, v251
    v_lshlrev_b32 v252, 23, v252
    v_lshlrev_b32 v253, 23, v253
    v_lshlrev_b32 v254, 23, v254
    v_lshlrev_b32 v255, 23, v255
    v_pk_mov_b32 v[64:65], 0, 0
    v_pk_mov_b32 v[66:67], 0, 0
    v_pk_mov_b32 v[68:69], 0, 0
    v_pk_mov_b32 v[70:71], 0, 0
    v_pk_mov_b32 v[72:73], 0, 0
    v_pk_mov_b32 v[74:75], 0, 0
    v_pk_mov_b32 v[76:77], 0, 0
    v_pk_mov_b32 v[78:79], 0, 0
    v_pk_mov_b32 v[80:81], 0, 0
    v_pk_mov_b32 v[82:83], 0, 0
    v_pk_mov_b32 v[84:85], 0, 0
    v_pk_mov_b32 v[86:87], 0, 0
    v_pk_mov_b32 v[88:89], 0, 0
    v_pk_mov_b32 v[90:91], 0, 0
    v_pk_mov_b32 v[92:93], 0, 0
    v_pk_mov_b32 v[94:95], 0, 0
    v_pk_mov_b32 v[96:97], 0, 0
    v_pk_mov_b32 v[98:99], 0, 0
    v_pk_mov_b32 v[100:101], 0, 0
    v_pk_mov_b32 v[102:103], 0, 0
    v_pk_mov_b32 v[104:105], 0, 0
    v_pk_mov_b32 v[106:107], 0, 0
    v_pk_mov_b32 v[108:109], 0, 0
    v_pk_mov_b32 v[110:111], 0, 0
    v_pk_mov_b32 v[112:113], 0, 0
    v_pk_mov_b32 v[114:115], 0, 0
    v_pk_mov_b32 v[116:117], 0, 0
    v_pk_mov_b32 v[118:119], 0, 0
    v_pk_mov_b32 v[120:121], 0, 0
    v_pk_mov_b32 v[122:123], 0, 0
    v_pk_mov_b32 v[124:125], 0, 0
    v_pk_mov_b32 v[126:127], 0, 0
    v_mov_b32 v11, 0
    s_waitcnt vmcnt(8)
    s_barrier
    s_cmp_ge_u32 s49, s48
    s_cbranch_scc1 L_idle_p2
    ds_read_b128 v[128:131], v22 offset:0
    ds_read_b128 v[160:163], v5 offset:0
    ds_read_b128 v[132:135], v23 offset:0
    ds_read_b128 v[164:167], v6 offset:0
    ds_read_b128 v[136:139], v22 offset:64
    ds_read_b128 v[168:171], v5 offset:64
    ds_read_b128 v[140:143], v23 offset:64
    ds_read_b128 v[172:175], v6 offset:64
    ds_read_b128 v[144:147], v22 offset:128
    ds_read_b128 v[176:179], v5 offset:128
    ds_read_b128 v[148:151], v23 offset:128
    ds_read_b128 v[180:183], v6 offset:128
    ds_read_b128 v[152:155], v22 offset:192
    ds_read_b128 v[184:187], v5 offset:192
    ds_read_b128 v[156:159], v23 offset:192
    ds_read_b128 v[188:191], v6 offset:192
    s_waitcnt lgkmcnt(14)
    v_mfma_f32_32x32x16_bf16 v[48:63], v[160:163], v[128:131], 0
    s_waitcnt lgkmcnt(12)
    v_mfma_f32_32x32x16_bf16 v[48:63], v[164:167], v[132:135], v[48:63]
    s_waitcnt lgkmcnt(10)
    v_mfma_f32_32x32x16_bf16 v[48:63], v[168:171], v[136:139], v[48:63]
    s_waitcnt lgkmcnt(8)
    v_mfma_f32_32x32x16_bf16 v[48:63], v[172:175], v[140:143], v[48:63]
    s_waitcnt lgkmcnt(6)
    v_mfma_f32_32x32x16_bf16 v[48:63], v[176:179], v[144:147], v[48:63]
    s_waitcnt lgkmcnt(4)
    v_mfma_f32_32x32x16_bf16 v[48:63], v[180:183], v[148:151], v[48:63]
    s_waitcnt lgkmcnt(2)
    v_mfma_f32_32x32x16_bf16 v[48:63], v[184:187], v[152:155], v[48:63]
    s_waitcnt lgkmcnt(0)
    v_mfma_f32_32x32x16_bf16 v[48:63], v[188:191], v[156:159], v[48:63]
    s_waitcnt vmcnt(6)
    s_barrier
    s_add_u32 m0, s52, 26112
    s_nop 0
    buffer_load_dwordx4 v1, s[12:15], s50 offen lds
    s_add_u32 m0, s52, 30464
    s_nop 0
    buffer_load_dwordx4 v3, s[12:15], s50 offen lds
    s_add_u32 s50, s50, 0x20000
    s_add_u32 m0, s53, 17408
    s_nop 0
    buffer_load_dwordx4 v2, s[16:19], s51 offen lds
    s_add_u32 m0, s53, 21760
    s_nop 0
    buffer_load_dwordx4 v4, s[16:19], s51 offen lds
    s_add_u32 s51, s51, 0x20000
    v_max3_f32 v16, v48, v49, v50
    v_max3_f32 v16, v16, v51, v52
    v_max3_f32 v16, v16, v53, v54
    v_max3_f32 v16, v16, v55, v56
    v_max3_f32 v16, v16, v57, v58
    v_max3_f32 v16, v16, v59, v60
    v_max3_f32 v16, v16, v61, v62
    v_max_f32 v16, v16, v63
    v_mov_b32 v17, v16
    s_nop 1
    v_permlane32_swap_b32 v16, v17
    v_max_f32 v16, v16, v17
    v_mul_f32 v10, s40, v16
    ds_read_b128 v[160:163], v5 offset:8704
    ds_read_b128 v[164:167], v6 offset:8704
    s_nop 0
    ds_read_b128 v[168:171], v5 offset:8768
    ds_read_b128 v[172:175], v6 offset:8768
    s_nop 0
    ds_read_b128 v[176:179], v5 offset:8832
    ds_read_b128 v[180:183], v6 offset:8832
    v_fma_f32 v32, v48, s40, -v10
    v_fma_f32 v33, v49, s40, -v10
    v_fma_f32 v34, v50, s40, -v10
    v_fma_f32 v35, v51, s40, -v10
    s_nop 0
    ds_read_b128 v[184:187], v5 offset:8896
    ds_read_b128 v[188:191], v6 offset:8896
    v_fma_f32 v36, v52, s40, -v10
    v_fma_f32 v37, v53, s40, -v10
    v_fma_f32 v38, v54, s40, -v10
    v_fma_f32 v39, v55, s40, -v10
    v_exp_f32 v18, v32
    v_exp_f32 v19, v33
    s_nop 0
    v_fma_f32 v40, v56, s40, -v10
    v_fma_f32 v41, v57, s40, -v10
    v_fma_f32 v42, v58, s40, -v10
    v_fma_f32 v43, v59, s40, -v10
    v_exp_f32 v20, v34
    v_exp_f32 v21, v35
    s_nop 0
    v_fma_f32 v44, v60, s40, -v10
    v_fma_f32 v45, v61, s40, -v10
    v_fma_f32 v46, v62, s40, -v10
    v_fma_f32 v47, v63, s40, -v10
    v_cvt_pk_bf16_f32 v24, v18, v19
    v_add_f32 v12, v18, v20
    v_add_f32 v13, v19, v21
    s_nop 0
    v_exp_f32 v22, v36
    v_exp_f32 v23, v37
    v_cvt_pk_bf16_f32 v25, v20, v21
    s_nop 0
    v_add_f32 v12, v12, v22
    v_add_f32 v13, v13, v23
    v_cvt_pk_bf16_f32 v26, v22, v23
    s_nop 0
L_loop:
    v_add_u32 v9, s64, v7
    v_add_u32 v14, s64, v8
    s_waitcnt vmcnt(6) lgkmcnt(0)
    s_barrier
    s_cmp_lg_u32 s43, s46
    s_cbranch_scc1 L_nm
    v_mfma_f32_32x32x16_bf16 v[48:63], v[160:163], v[128:131], v[240:255]
    s_branch L_m
L_nm:
    v_mfma_f32_32x32x16_bf16 v[48:63], v[160:163], v[128:131], 0
L_m:
    ds_read_b64_tr_b16 v[192:193], v9 offset:0
    ds_read_b64_tr_b16 v[194:195], v9 offset:512
    v_exp_f32 v16, v38
    v_exp_f32 v17, v39
    v_mfma_f32_32x32x16_bf16 v[48:63], v[164:167], v[132:135], v[48:63]
    ds_read_b64_tr_b16 v[196:197], v9 offset:64
    ds_read_b64_tr_b16 v[198:199], v9 offset:576
    v_exp_f32 v18, v40
    v_add_f32 v12, v12, v16
    v_add_f32 v13, v13, v17
    v_cvt_pk_bf16_f32 v27, v16, v17
    v_mfma_f32_32x32x16_bf16 v[48:63], v[168:171], v[136:139], v[48:63]
    s_add_u32 m0, s52, s64
    ds_read_b64_tr_b16 v[200:201], v14 offset:0
    ds_read_b64_tr_b16 v[202:203], v14 offset:512
    v_exp_f32 v19, v41
    v_exp_f32 v20, v42
    buffer_load_dwordx4 v1, s[12:15], s50 offen lds
    v_mfma_f32_32x32x16_bf16 v[48:63], v[172:175], v[140:143], v[48:63]
    ds_read_b64_tr_b16 v[204:205], v14 offset:64
    ds_read_b64_tr_b16 v[206:207], v14 offset:576
    v_exp_f32 v21, v43
    v_add_f32 v12, v12, v18
    v_add_f32 v13, v13, v19
    v_cvt_pk_bf16_f32 v28, v18, v19
    v_mfma_f32_32x32x16_bf16 v[48:63], v[176:179], v[144:147], v[48:63]
    ds_read_b64_tr_b16 v[208:209], v9 offset:4352
    ds_read_b64_tr_b16 v[210:211], v9 offset:4864
    v_exp_f32 v22, v44
    v_add_f32 v12, v12, v20
    v_add_f32 v13, v13, v21
    v_cvt_pk_bf16_f32 v29, v20, v21
    v_mfma_f32_32x32x16_bf16 v[48:63], v[180:183], v[148:151], v[48:63]
    s_add_u32 m0, s67, s64
    ds_read_b64_tr_b16 v[212:213], v9 offset:4416
    ds_read_b64_tr_b16 v[214:215], v9 offset:4928
    v_exp_f32 v23, v45
    v_exp_f32 v16, v46
    buffer_load_dwordx4 v3, s[12:15], s50 offen lds
    s_add_u32 s50, s50, 0x20000
    v_mfma_f32_32x32x16_bf16 v[48:63], v[184:187], v[152:155], v[48:63]
    ds_read_b64_tr_b16 v[216:217], v14 offset:4352
    ds_read_b64_tr_b16 v[218:219], v14 offset:4864
    v_exp_f32 v17, v47
    v_add_f32 v12, v12, v22
    v_add_f32 v13, v13, v23
    v_cvt_pk_bf16_f32 v30, v22, v23
    v_mfma_f32_32x32x16_bf16 v[48:63], v[188:191], v[156:159], v[48:63]
    ds_read_b64_tr_b16 v[220:221], v14 offset:4416
    ds_read_b64_tr_b16 v[222:223], v14 offset:4928
    v_add_f32 v12, v12, v16
    v_add_f32 v13, v13, v17
    v_cvt_pk_bf16_f32 v31, v16, v17
    v_add_u32 v224, s65, v5
    v_add_u32 v225, s65, v6
    v_add_f32 v15, v12, v13
    v_cmp_lt_f32 vcc, s42, v15
    s_cbranch_vccnz L_rsl
L_retl:
    v_add_f32 v11, v11, v15
    s_waitcnt lgkmcnt(14)
    v_mfma_f32_32x32x16_bf16 v[64:79], v[192:195], v[24:27], v[64:79]
    s_add_u32 m0, s53, s66
    ds_read_b128 v[160:163], v224 offset:0
    ds_read_b128 v[164:167], v225 offset:0
    buffer_load_dwordx4 v2, s[16:19], s51 offen lds
    s_waitcnt lgkmcnt(14)
    v_mfma_f32_32x32x16_bf16 v[80:95], v[196:199], v[24:27], v[80:95]
    s_add_u32 m0, s68, s66
    ds_read_b128 v[168:171], v224 offset:64
    ds_read_b128 v[172:175], v225 offset:64
    buffer_load_dwordx4 v4, s[16:19], s51 offen lds
    s_add_u32 s51, s51, 0x20000
    s_waitcnt lgkmcnt(14)
    v_mfma_f32_32x32x16_bf16 v[96:111], v[200:203], v[24:27], v[96:111]
    ds_read_b128 v[176:179], v224 offset:128
    ds_read_b128 v[180:183], v225 offset:128
    v_fma_f32 v32, v48, s40, -v10
    v_fma_f32 v33, v49, s40, -v10
    v_fma_f32 v34, v50, s40, -v10
    v_fma_f32 v35, v51, s40, -v10
    s_waitcnt lgkmcnt(14)
    v_mfma_f32_32x32x16_bf16 v[112:127], v[204:207], v[24:27], v[112:127]
    ds_read_b128 v[184:187], v224 offset:192
    ds_read_b128 v[188:191], v225 offset:192
    v_fma_f32 v36, v52, s40, -v10
    v_fma_f32 v37, v53, s40, -v10
    v_fma_f32 v38, v54, s40, -v10
    v_fma_f32 v39, v55, s40, -v10
    v_exp_f32 v18, v32
    v_exp_f32 v19, v33
    s_waitcnt lgkmcnt(14)
    v_mfma_f32_32x32x16_bf16 v[64:79], v[208:211], v[28:31], v[64:79]
    v_fma_f32 v40, v56, s40, -v10
    v_fma_f32 v41, v57, s40, -v10
    v_fma_f32 v42, v58, s40, -v10
    v_fma_f32 v43, v59, s40, -v10
    v_exp_f32 v20, v34
    v_exp_f32 v21, v35
    s_waitcnt lgkmcnt(12)
    v_mfma_f32_32x32x16_bf16 v[80:95], v[212:215], v[28:31], v[80:95]
    v_fma_f32 v44, v60, s40, -v10
    v_fma_f32 v45, v61, s40, -v10
    v_fma_f32 v46, v62, s40, -v10
    v_fma_f32 v47, v63, s40, -v10
    v_cvt_pk_bf16_f32 v24, v18, v19
    v_add_f32 v12, v18, v20
    v_add_f32 v13, v19, v21
    s_waitcnt lgkmcnt(10)
    v_mfma_f32_32x32x16_bf16 v[96:111], v[216:219], v[28:31], v[96:111]
    v_exp_f32 v22, v36
    v_exp_f32 v23, v37
    v_cvt_pk_bf16_f32 v25, v20, v21
    s_waitcnt lgkmcnt(8)
    v_mfma_f32_32x32x16_bf16 v[112:127], v[220:223], v[28:31], v[112:127]
    v_add_f32 v12, v12, v22
    v_add_f32 v13, v13, v23
    v_cvt_pk_bf16_f32 v26, v22, v23
    s_mov_b32 s65, s66
    s_mov_b32 s66, s64
    s_add_u32 s64, s64, 8704
    s_cmp_eq_u32 s64, 34816
    s_cselect_b32 s64, 0, s64
    s_add_u32 s43, s43, 1
    s_cmp_le_u32 s43, s46
    s_cbranch_scc1 L_loop
    v_add_u32 v9, s64, v7
    v_add_u32 v14, s64, v8
    s_waitcnt vmcnt(6) lgkmcnt(0)
    s_barrier
    ds_read_b64_tr_b16 v[192:193], v9 offset:0
    ds_read_b64_tr_b16 v[194:195], v9 offset:512
    v_exp_f32 v16, v38
    v_exp_f32 v17, v39
    s_nop 0
    ds_read_b64_tr_b16 v[196:197], v9 offset:64
    ds_read_b64_tr_b16 v[198:199], v9 offset:576
    v_exp_f32 v18, v40
    v_add_f32 v12, v12, v16
    v_add_f32 v13, v13, v17
    v_cvt_pk_bf16_f32 v27, v16, v17
    s_nop 0
    ds_read_b64_tr_b16 v[200:201], v14 offset:0
    ds_read_b64_tr_b16 v[202:203], v14 offset:512
    v_exp_f32 v19, v41
    v_exp_f32 v20, v42
    s_nop 0
    ds_read_b64_tr_b16 v[204:205], v14 offset:64
    ds_read_b64_tr_b16 v[206:207], v14 offset:576
    v_exp_f32 v21, v43
    v_add_f32 v12, v12, v18
    v_add_f32 v13, v13, v19
    v_cvt_pk_bf16_f32 v28, v18, v19
    s_nop 0
    ds_read_b64_tr_b16 v[208:209], v9 offset:4352
    ds_read_b64_tr_b16 v[210:211], v9 offset:4864
    v_exp_f32 v22, v44
    v_add_f32 v12, v12, v20
    v_add_f32 v13, v13, v21
    v_cvt_pk_bf16_f32 v29, v20, v21
    s_nop 0
    ds_read_b64_tr_b16 v[212:213], v9 offset:4416
    ds_read_b64_tr_b16 v[214:215], v9 offset:4928
    v_exp_f32 v23, v45
    v_exp_f32 v16, v46
    s_nop 0
    ds_read_b64_tr_b16 v[216:217], v14 offset:4352
    ds_read_b64_tr_b16 v[218:219], v14 offset:4864
    v_exp_f32 v17, v47
    v_add_f32 v12, v12, v22
    v_add_f32 v13, v13, v23
    v_cvt_pk_bf16_f32 v30, v22, v23
    s_nop 0
    ds_read_b64_tr_b16 v[220:221], v14 offset:4416
    ds_read_b64_tr_b16 v[222:223], v14 offset:4928
    v_add_f32 v12, v12, v16
    v_add_f32 v13, v13, v17
    v_cvt_pk_bf16_f32 v31, v16, v17
    s_nop 0
    v_add_f32 v15, v12, v13
    v_cmp_lt_f32 vcc, s42, v15
    s_cbranch_vccnz L_rst
L_rett:
    v_add_f32 v11, v11, v15
    s_nop 1
    s_waitcnt lgkmcnt(14)
    v_mfma_f32_32x32x16_bf16 v[64:79], v[192:195], v[24:27], v[64:79]
    s_waitcnt lgkmcnt(12)
    v_mfma_f32_32x32x16_bf16 v[80:95], v[196:199], v[24:27], v[80:95]
    s_waitcnt lgkmcnt(10)
    v_mfma_f32_32x32x16_bf16 v[96:111], v[200:203], v[24:27], v[96:111]
    s_waitcnt lgkmcnt(8)
    v_mfma_f32_32x32x16_bf16 v[112:127], v[204:207], v[24:27], v[112:127]
    s_waitcnt lgkmcnt(6)
    v_mfma_f32_32x32x16_bf16 v[64:79], v[208:211], v[28:31], v[64:79]
    s_waitcnt lgkmcnt(4)
    v_mfma_f32_32x32x16_bf16 v[80:95], v[212:215], v[28:31], v[80:95]
    s_waitcnt lgkmcnt(2)
    v_mfma_f32_32x32x16_bf16 v[96:111], v[216:219], v[28:31], v[96:111]
    s_waitcnt lgkmcnt(0)
    v_mfma_f32_32x32x16_bf16 v[112:127], v[220:223], v[28:31], v[112:127]
    s_add_u32 s43, s43, 1
L_service:
    s_cmp_ge_u32 s43, s45
    s_cbranch_scc1 L_epi
    s_barrier
    s_add_u32 s43, s43, 1
    s_branch L_service
L_epi:
    v_mov_b32 v16, v11
    s_waitcnt vmcnt(0)
    s_nop 0
    v_permlane32_swap_b32 v11, v16
    v_add_f32 v11, v11, v16
    s_cmp_eq_u32 s47, 0
    s_cbranch_scc1 L_nomerge
    v_lshlrev_b32 v16, 4, v0
    v_add_u32 v17, s52, v16
    s_add_u32 s33, s52, 69632
    s_sub_u32 s35, s52, 69632
    s_cmp_eq_u32 s6, 0
    s_cselect_b32 s35, s33, s35
    v_add_u32 v224, s35, v16
    s_lshl_b32 s35, s3, 9
    s_add_u32 s35, s35, 139264
    v_lshlrev_b32 v16, 3, v0
    v_add_u32 v225, s35, v16
    v_xor_b32 v226, 0x800, v225
    s_nop 3
    ds_write_b128 v17, v[96:99] offset:0
    ds_write_b128 v17, v[100:103] offset:4352
    ds_write_b128 v17, v[104:107] offset:8704
    ds_write_b128 v17, v[108:111] offset:13056
    ds_write_b128 v17, v[112:115] offset:17408
    ds_write_b128 v17, v[116:119] offset:21760
    ds_write_b128 v17, v[120:123] offset:26112
    ds_write_b128 v17, v[124:127] offset:30464
    ds_write_b64 v225, v[10:11]
    s_waitcnt lgkmcnt(0)
    s_barrier
    ds_read_b64 v[18:19], v226
    ds_read_b128 v[160:163], v224 offset:0
    ds_read_b128 v[164:167], v224 offset:4352
    ds_read_b128 v[168:171], v224 offset:8704
    ds_read_b128 v[172:175], v224 offset:13056
    ds_read_b128 v[176:179], v224 offset:17408
    ds_read_b128 v[180:183], v224 offset:21760
    ds_read_b128 v[184:187], v224 offset:26112
    ds_read_b128 v[188:191], v224 offset:30464
    s_waitcnt lgkmcnt(8)
    v_max_f32 v16, v10, v18
    v_sub_f32 v20, v10, v16
    v_sub_f32 v22, v18, v16
    v_exp_f32 v20, v20
    v_exp_f32 v22, v22
    s_nop 0
    v_mul_f32 v11, v11, v20
    v_fmac_f32 v11, v19, v22
    v_rcp_f32 v11, v11
    s_nop 0
    v_mul_f32 v20, v20, v11
    v_mul_f32 v22, v22, v11
    v_pk_mul_f32 v[64:65], v[64:65], v[20:21] op_sel_hi:[1,0]
    v_pk_mul_f32 v[66:67], v[66:67], v[20:21] op_sel_hi:[1,0]
    v_pk_mul_f32 v[68:69], v[68:69], v[20:21] op_sel_hi:[1,0]
    v_pk_mul_f32 v[70:71], v[70:71], v[20:21] op_sel_hi:[1,0]
    v_pk_mul_f32 v[72:73], v[72:73], v[20:21] op_sel_hi:[1,0]
    v_pk_mul_f32 v[74:75], v[74:75], v[20:21] op_sel_hi:[1,0]
    v_pk_mul_f32 v[76:77], v[76:77], v[20:21] op_sel_hi:[1,0]
    v_pk_mul_f32 v[78:79], v[78:79], v[20:21] op_sel_hi:[1,0]
    v_pk_mul_f32 v[80:81], v[80:81], v[20:21] op_sel_hi:[1,0]
    v_pk_mul_f32 v[82:83], v[82:83], v[20:21] op_sel_hi:[1,0]
    v_pk_mul_f32 v[84:85], v[84:85], v[20:21] op_sel_hi:[1,0]
    v_pk_mul_f32 v[86:87], v[86:87], v[20:21] op_sel_hi:[1,0]
    v_pk_mul_f32 v[88:89], v[88:89], v[20:21] op_sel_hi:[1,0]
    v_pk_mul_f32 v[90:91], v[90:91], v[20:21] op_sel_hi:[1,0]
    v_pk_mul_f32 v[92:93], v[92:93], v[20:21] op_sel_hi:[1,0]
    v_pk_mul_f32 v[94:95], v[94:95], v[20:21] op_sel_hi:[1,0]
    s_waitcnt lgkmcnt(7)
    v_pk_fma_f32 v[64:65], v[160:161], v[22:23], v[64:65] op_sel_hi:[1,0,1]
    v_pk_fma_f32 v[66:67], v[162:163], v[22:23], v[66:67] op_sel_hi:[1,0,1]
    s_waitcnt lgkmcnt(6)
    v_pk_fma_f32 v[68:69], v[164:165], v[22:23], v[68:69] op_sel_hi:[1,0,1]
    v_pk_fma_f32 v[70:71], v[166:167], v[22:23], v[70:71] op_sel_hi:[1,0,1]
    s_waitcnt lgkmcnt(5)
    v_pk_fma_f32 v[72:73], v[168:169], v[22:23], v[72:73] op_sel_hi:[1,0,1]
    v_pk_fma_f32 v[74:75], v[170:171], v[22:23], v[74:75] op_sel_hi:[1,0,1]
    s_waitcnt lgkmcnt(4)
    v_pk_fma_f32 v[76:77], v[172:173], v[22:23], v[76:77] op_sel_hi:[1,0,1]
    v_pk_fma_f32 v[78:79], v[174:175], v[22:23], v[78:79] op_sel_hi:[1,0,1]
    s_waitcnt lgkmcnt(3)
    v_pk_fma_f32 v[80:81], v[176:177], v[22:23], v[80:81] op_sel_hi:[1,0,1]
    v_pk_fma_f32 v[82:83], v[178:179], v[22:23], v[82:83] op_sel_hi:[1,0,1]
    s_waitcnt lgkmcnt(2)
    v_pk_fma_f32 v[84:85], v[180:181], v[22:23], v[84:85] op_sel_hi:[1,0,1]
    v_pk_fma_f32 v[86:87], v[182:183], v[22:23], v[86:87] op_sel_hi:[1,0,1]
    s_waitcnt lgkmcnt(1)
    v_pk_fma_f32 v[88:89], v[184:185], v[22:23], v[88:89] op_sel_hi:[1,0,1]
    v_pk_fma_f32 v[90:91], v[186:187], v[22:23], v[90:91] op_sel_hi:[1,0,1]
    s_waitcnt lgkmcnt(0)
    v_pk_fma_f32 v[92:93], v[188:189], v[22:23], v[92:93] op_sel_hi:[1,0,1]
    v_pk_fma_f32 v[94:95], v[190:191], v[22:23], v[94:95] op_sel_hi:[1,0,1]
    s_branch L_store
L_nomerge:
    v_rcp_f32 v20, v11
    s_nop 7
    v_pk_mul_f32 v[64:65], v[64:65], v[20:21] op_sel_hi:[1,0]
    v_pk_mul_f32 v[66:67], v[66:67], v[20:21] op_sel_hi:[1,0]
    v_pk_mul_f32 v[68:69], v[68:69], v[20:21] op_sel_hi:[1,0]
    v_pk_mul_f32 v[70:71], v[70:71], v[20:21] op_sel_hi:[1,0]
    v_pk_mul_f32 v[72:73], v[72:73], v[20:21] op_sel_hi:[1,0]
    v_pk_mul_f32 v[74:75], v[74:75], v[20:21] op_sel_hi:[1,0]
    v_pk_mul_f32 v[76:77], v[76:77], v[20:21] op_sel_hi:[1,0]
    v_pk_mul_f32 v[78:79], v[78:79], v[20:21] op_sel_hi:[1,0]
    v_pk_mul_f32 v[80:81], v[80:81], v[20:21] op_sel_hi:[1,0]
    v_pk_mul_f32 v[82:83], v[82:83], v[20:21] op_sel_hi:[1,0]
    v_pk_mul_f32 v[84:85], v[84:85], v[20:21] op_sel_hi:[1,0]
    v_pk_mul_f32 v[86:87], v[86:87], v[20:21] op_sel_hi:[1,0]
    v_pk_mul_f32 v[88:89], v[88:89], v[20:21] op_sel_hi:[1,0]
    v_pk_mul_f32 v[90:91], v[90:91], v[20:21] op_sel_hi:[1,0]
    v_pk_mul_f32 v[92:93], v[92:93], v[20:21] op_sel_hi:[1,0]
    v_pk_mul_f32 v[94:95], v[94:95], v[20:21] op_sel_hi:[1,0]
    v_pk_mul_f32 v[96:97], v[96:97], v[20:21] op_sel_hi:[1,0]
    v_pk_mul_f32 v[98:99], v[98:99], v[20:21] op_sel_hi:[1,0]
    v_pk_mul_f32 v[100:101], v[100:101], v[20:21] op_sel_hi:[1,0]
    v_pk_mul_f32 v[102:103], v[102:103], v[20:21] op_sel_hi:[1,0]
    v_pk_mul_f32 v[104:105], v[104:105], v[20:21] op_sel_hi:[1,0]
    v_pk_mul_f32 v[106:107], v[106:107], v[20:21] op_sel_hi:[1,0]
    v_pk_mul_f32 v[108:109], v[108:109], v[20:21] op_sel_hi:[1,0]
    v_pk_mul_f32 v[110:111], v[110:111], v[20:21] op_sel_hi:[1,0]
    v_pk_mul_f32 v[112:113], v[112:113], v[20:21] op_sel_hi:[1,0]
    v_pk_mul_f32 v[114:115], v[114:115], v[20:21] op_sel_hi:[1,0]
    v_pk_mul_f32 v[116:117], v[116:117], v[20:21] op_sel_hi:[1,0]
    v_pk_mul_f32 v[118:119], v[118:119], v[20:21] op_sel_hi:[1,0]
    v_pk_mul_f32 v[120:121], v[120:121], v[20:21] op_sel_hi:[1,0]
    v_pk_mul_f32 v[122:123], v[122:123], v[20:21] op_sel_hi:[1,0]
    v_pk_mul_f32 v[124:125], v[124:125], v[20:21] op_sel_hi:[1,0]
    v_pk_mul_f32 v[126:127], v[126:127], v[20:21] op_sel_hi:[1,0]
L_store:
    s_cmp_lg_u32 s47, 0
    s_cselect_b32 s60, s53, s52
    s_cselect_b32 s61, 0, s56
    v_and_b32 v16, 31, v0
    v_lshrrev_b32 v17, 3, v16
    v_mul_u32_u24 v17, 8704, v17
    v_bfe_u32 v18, v16, 2, 1
    v_mul_u32_u24 v18, 4352, v18
    v_and_b32 v19, 3, v16
    v_mul_u32_u24 v19, 272, v19
    v_add3_u32 v17, v17, v18, v19
    v_lshrrev_b32 v16, 5, v0
    v_lshl_add_u32 v17, v16, 4, v17
    v_add_u32 v17, s60, v17
    v_add_u32 v224, s61, v17
    v_add_u32 v225, s57, v17
    v_cvt_pk_bf16_f32 v192, v64, v65
    v_cvt_pk_bf16_f32 v193, v66, v67
    v_cvt_pk_bf16_f32 v194, v68, v69
    v_cvt_pk_bf16_f32 v195, v70, v71
    s_nop 1
    v_permlane32_swap_b32 v192, v194
    v_permlane32_swap_b32 v193, v195
    ds_write_b128 v224, v[192:195] offset:0
    v_cvt_pk_bf16_f32 v196, v72, v73
    v_cvt_pk_bf16_f32 v197, v74, v75
    v_cvt_pk_bf16_f32 v198, v76, v77
    v_cvt_pk_bf16_f32 v199, v78, v79
    s_nop 1
    v_permlane32_swap_b32 v196, v198
    v_permlane32_swap_b32 v197, v199
    ds_write_b128 v224, v[196:199] offset:32
    v_cvt_pk_bf16_f32 v200, v80, v81
    v_cvt_pk_bf16_f32 v201, v82, v83
    v_cvt_pk_bf16_f32 v202, v84, v85
    v_cvt_pk_bf16_f32 v203, v86, v87
    s_nop 1
    v_permlane32_swap_b32 v200, v202
    v_permlane32_swap_b32 v201, v203
    ds_write_b128 v224, v[200:203] offset:64
    v_cvt_pk_bf16_f32 v204, v88, v89
    v_cvt_pk_bf16_f32 v205, v90, v91
    v_cvt_pk_bf16_f32 v206, v92, v93
    v_cvt_pk_bf16_f32 v207, v94, v95
    s_nop 1
    v_permlane32_swap_b32 v204, v206
    v_permlane32_swap_b32 v205, v207
    ds_write_b128 v224, v[204:207] offset:96
    s_lshl_b32 s35, s49, 12
    s_add_u32 s35, s35, s34
    s_cmp_lg_u32 s47, 0
    s_cbranch_scc1 L_st_merge
    v_cvt_pk_bf16_f32 v208, v96, v97
    v_cvt_pk_bf16_f32 v209, v98, v99
    v_cvt_pk_bf16_f32 v210, v100, v101
    v_cvt_pk_bf16_f32 v211, v102, v103
    s_nop 1
    v_permlane32_swap_b32 v208, v210
    v_permlane32_swap_b32 v209, v211
    ds_write_b128 v225, v[208:211] offset:0
    v_cvt_pk_bf16_f32 v212, v104, v105
    v_cvt_pk_bf16_f32 v213, v106, v107
    v_cvt_pk_bf16_f32 v214, v108, v109
    v_cvt_pk_bf16_f32 v215, v110, v111
    s_nop 1
    v_permlane32_swap_b32 v212, v214
    v_permlane32_swap_b32 v213, v215
    ds_write_b128 v225, v[212:215] offset:32
    v_cvt_pk_bf16_f32 v216, v112, v113
    v_cvt_pk_bf16_f32 v217, v114, v115
    v_cvt_pk_bf16_f32 v218, v116, v117
    v_cvt_pk_bf16_f32 v219, v118, v119
    s_nop 1
    v_permlane32_swap_b32 v216, v218
    v_permlane32_swap_b32 v217, v219
    ds_write_b128 v225, v[216:219] offset:64
    v_cvt_pk_bf16_f32 v220, v120, v121
    v_cvt_pk_bf16_f32 v221, v122, v123
    v_cvt_pk_bf16_f32 v222, v124, v125
    v_cvt_pk_bf16_f32 v223, v126, v127
    s_nop 1
    v_permlane32_swap_b32 v220, v222
    v_permlane32_swap_b32 v221, v223
    ds_write_b128 v225, v[220:223] offset:96
    v_lshrrev_b32 v16, 4, v0
    v_and_b32 v17, 15, v0
    v_lshlrev_b32 v17, 4, v17
    v_mul_u32_u24 v18, 272, v16
    v_add3_u32 v18, v18, v17, s60
    v_lshl_add_u32 v19, v16, 12, v17
    s_waitcnt lgkmcnt(0)
    ds_read_b128 v[160:163], v18 offset:0
    ds_read_b128 v[164:167], v18 offset:4352
    ds_read_b128 v[168:171], v18 offset:8704
    ds_read_b128 v[172:175], v18 offset:13056
    ds_read_b128 v[176:179], v18 offset:17408
    ds_read_b128 v[180:183], v18 offset:21760
    ds_read_b128 v[184:187], v18 offset:26112
    ds_read_b128 v[188:191], v18 offset:30464
    s_waitcnt lgkmcnt(7)
    buffer_store_dwordx4 v[160:163], v19, s[20:23], s35 offen nt
    s_add_u32 s35, s35, 0x4000
    s_waitcnt lgkmcnt(6)
    buffer_store_dwordx4 v[164:167], v19, s[20:23], s35 offen nt
    s_add_u32 s35, s35, 0x4000
    s_waitcnt lgkmcnt(5)
    buffer_store_dwordx4 v[168:171], v19, s[20:23], s35 offen nt
    s_add_u32 s35, s35, 0x4000
    s_waitcnt lgkmcnt(4)
    buffer_store_dwordx4 v[172:175], v19, s[20:23], s35 offen nt
    s_add_u32 s35, s35, 0x4000
    s_waitcnt lgkmcnt(3)
    buffer_store_dwordx4 v[176:179], v19, s[20:23], s35 offen nt
    s_add_u32 s35, s35, 0x4000
    s_waitcnt lgkmcnt(2)
    buffer_store_dwordx4 v[180:183], v19, s[20:23], s35 offen nt
    s_add_u32 s35, s35, 0x4000
    s_waitcnt lgkmcnt(1)
    buffer_store_dwordx4 v[184:187], v19, s[20:23], s35 offen nt
    s_add_u32 s35, s35, 0x4000
    s_waitcnt lgkmcnt(0)
    buffer_store_dwordx4 v[188:191], v19, s[20:23], s35 offen nt
    s_branch L_fin
L_st_merge:
    v_lshrrev_b32 v16, 3, v0
    v_and_b32 v17, 7, v0
    v_lshlrev_b32 v17, 4, v17
    v_and_b32 v18, 3, v16
    v_mul_u32_u24 v18, 272, v18
    v_lshrrev_b32 v19, 5, v0
    v_mul_u32_u24 v19, 4352, v19
    v_add3_u32 v18, v18, v19, v17
    v_add_u32 v18, s60, v18
    v_lshl_add_u32 v19, v16, 12, v17
    s_add_u32 s35, s35, s56
    s_waitcnt lgkmcnt(0)
    ds_read_b128 v[160:163], v18 offset:0
    ds_read_b128 v[164:167], v18 offset:8704
    ds_read_b128 v[168:171], v18 offset:17408
    ds_read_b128 v[172:175], v18 offset:26112
    s_waitcnt lgkmcnt(3)
    buffer_store_dwordx4 v[160:163], v19, s[20:23], s35 offen nt
    s_add_u32 s35, s35, 0x8000
    s_waitcnt lgkmcnt(2)
    buffer_store_dwordx4 v[164:167], v19, s[20:23], s35 offen nt
    s_add_u32 s35, s35, 0x8000
    s_waitcnt lgkmcnt(1)
    buffer_store_dwordx4 v[168:171], v19, s[20:23], s35 offen nt
    s_add_u32 s35, s35, 0x8000
    s_waitcnt lgkmcnt(0)
    buffer_store_dwordx4 v[172:175], v19, s[20:23], s35 offen nt
L_fin:
    s_endpgm
L_idle_p2:
    s_waitcnt vmcnt(6)
    s_barrier
    s_add_u32 m0, s52, 26112
    s_nop 0
    buffer_load_dwordx4 v1, s[12:15], s50 offen lds
    s_add_u32 m0, s52, 30464
    s_nop 0
    buffer_load_dwordx4 v3, s[12:15], s50 offen lds
    s_add_u32 s50, s50, 0x20000
    s_add_u32 m0, s53, 17408
    s_nop 0
    buffer_load_dwordx4 v2, s[16:19], s51 offen lds
    s_add_u32 m0, s53, 21760
    s_nop 0
    buffer_load_dwordx4 v4, s[16:19], s51 offen lds
    s_add_u32 s51, s51, 0x20000
L_idle_loop:
    s_waitcnt vmcnt(6)
    s_barrier
    s_add_u32 m0, s52, s64
    s_nop 0
    buffer_load_dwordx4 v1, s[12:15], s50 offen lds
    s_add_u32 m0, s67, s64
    s_nop 0
    buffer_load_dwordx4 v3, s[12:15], s50 offen lds
    s_add_u32 s50, s50, 0x20000
    s_add_u32 m0, s53, s66
    s_nop 0
    buffer_load_dwordx4 v2, s[16:19], s51 offen lds
    s_add_u32 m0, s68, s66
    s_nop 0
    buffer_load_dwordx4 v4, s[16:19], s51 offen lds
    s_add_u32 s51, s51, 0x20000
    s_mov_b32 s65, s66
    s_mov_b32 s66, s64
    s_add_u32 s64, s64, 8704
    s_cmp_eq_u32 s64, 34816
    s_cselect_b32 s64, 0, s64
    s_add_u32 s43, s43, 1
    s_cmp_lt_u32 s43, s45
    s_cbranch_scc1 L_idle_loop
L_idle_epi:
    s_waitcnt vmcnt(0)
    s_cmp_eq_u32 s47, 0
    s_cbranch_scc1 L_end
    s_barrier
L_end:
    s_endpgm
L_rsl:
    s_swappc_b64 s[76:77], s[80:81]
    s_branch L_retl
L_rst:
    s_swappc_b64 s[76:77], s[80:81]
    s_branch L_rett
L_rare:
    v_max3_f32 v16, v32, v33, v34
    v_max3_f32 v16, v16, v35, v36
    v_max3_f32 v16, v16, v37, v38
    v_max3_f32 v16, v16, v39, v40
    v_max3_f32 v16, v16, v41, v42
    v_max3_f32 v16, v16, v43, v44
    v_max3_f32 v16, v16, v45, v46
    v_max_f32 v16, v16, v47
    v_mov_b32 v17, v16
    s_nop 1
    v_permlane32_swap_b32 v16, v17
    v_max3_f32 v16, v16, v17, 0
    v_add_f32 v10, v10, v16
    v_exp_f32 v17, -v16
    s_nop 0
    v_mul_f32 v11, v11, v17
    v_mul_f32 v64, v64, v17
    v_mul_f32 v65, v65, v17
    v_mul_f32 v66, v66, v17
    v_mul_f32 v67, v67, v17
    v_mul_f32 v68, v68, v17
    v_mul_f32 v69, v69, v17
    v_mul_f32 v70, v70, v17
    v_mul_f32 v71, v71, v17
    v_mul_f32 v72, v72, v17
    v_mul_f32 v73, v73, v17
    v_mul_f32 v74, v74, v17
    v_mul_f32 v75, v75, v17
    v_mul_f32 v76, v76, v17
    v_mul_f32 v77, v77, v17
    v_mul_f32 v78, v78, v17
    v_mul_f32 v79, v79, v17
    v_mul_f32 v80, v80, v17
    v_mul_f32 v81, v81, v17
    v_mul_f32 v82, v82, v17
    v_mul_f32 v83, v83, v17
    v_mul_f32 v84, v84, v17
    v_mul_f32 v85, v85, v17
    v_mul_f32 v86, v86, v17
    v_mul_f32 v87, v87, v17
    v_mul_f32 v88, v88, v17
    v_mul_f32 v89, v89, v17
    v_mul_f32 v90, v90, v17
    v_mul_f32 v91, v91, v17
    v_mul_f32 v92, v92, v17
    v_mul_f32 v93, v93, v17
    v_mul_f32 v94, v94, v17
    v_mul_f32 v95, v95, v17
    v_mul_f32 v96, v96, v17
    v_mul_f32 v97, v97, v17
    v_mul_f32 v98, v98, v17
    v_mul_f32 v99, v99, v17
    v_mul_f32 v100, v100, v17
    v_mul_f32 v101, v101, v17
    v_mul_f32 v102, v102, v17
    v_mul_f32 v103, v103, v17
    v_mul_f32 v104, v104, v17
    v_mul_f32 v105, v105, v17
    v_mul_f32 v106, v106, v17
    v_mul_f32 v107, v107, v17
    v_mul_f32 v108, v108, v17
    v_mul_f32 v109, v109, v17
    v_mul_f32 v110, v110, v17
    v_mul_f32 v111, v111, v17
    v_mul_f32 v112, v112, v17
    v_mul_f32 v113, v113, v17
    v_mul_f32 v114, v114, v17
    v_mul_f32 v115, v115, v17
    v_mul_f32 v116, v116, v17
    v_mul_f32 v117, v117, v17
    v_mul_f32 v118, v118, v17
    v_mul_f32 v119, v119, v17
    v_mul_f32 v120, v120, v17
    v_mul_f32 v121, v121, v17
    v_mul_f32 v122, v122, v17
    v_mul_f32 v123, v123, v17
    v_mul_f32 v124, v124, v17
    v_mul_f32 v125, v125, v17
    v_mul_f32 v126, v126, v17
    v_mul_f32 v127, v127, v17
    v_sub_f32 v32, v32, v16
    v_sub_f32 v33, v33, v16
    v_sub_f32 v34, v34, v16
    v_sub_f32 v35, v35, v16
    v_sub_f32 v36, v36, v16
    v_sub_f32 v37, v37, v16
    v_sub_f32 v38, v38, v16
    v_sub_f32 v39, v39, v16
    v_sub_f32 v40, v40, v16
    v_sub_f32 v41, v41, v16
    v_sub_f32 v42, v42, v16
    v_sub_f32 v43, v43, v16
    v_sub_f32 v44, v44, v16
    v_sub_f32 v45, v45, v16
    v_sub_f32 v46, v46, v16
    v_sub_f32 v47, v47, v16
    v_mov_b32 v15, 0
    v_exp_f32 v18, v32
    v_exp_f32 v19, v33
    s_nop 0
    v_add_f32 v15, v15, v18
    v_add_f32 v15, v15, v19
    v_cvt_pk_bf16_f32 v24, v18, v19
    v_exp_f32 v20, v34
    v_exp_f32 v21, v35
    s_nop 0
    v_add_f32 v15, v15, v20
    v_add_f32 v15, v15, v21
    v_cvt_pk_bf16_f32 v25, v20, v21
    v_exp_f32 v18, v36
    v_exp_f32 v19, v37
    s_nop 0
    v_add_f32 v15, v15, v18
    v_add_f32 v15, v15, v19
    v_cvt_pk_bf16_f32 v26, v18, v19
    v_exp_f32 v20, v38
    v_exp_f32 v21, v39
    s_nop 0
    v_add_f32 v15, v15, v20
    v_add_f32 v15, v15, v21
    v_cvt_pk_bf16_f32 v27, v20, v21
    v_exp_f32 v18, v40
    v_exp_f32 v19, v41
    s_nop 0
    v_add_f32 v15, v15, v18
    v_add_f32 v15, v15, v19
    v_cvt_pk_bf16_f32 v28, v18, v19
    v_exp_f32 v20, v42
    v_exp_f32 v21, v43
    s_nop 0
    v_add_f32 v15, v15, v20
    v_add_f32 v15, v15, v21
    v_cvt_pk_bf16_f32 v29, v20, v21
    v_exp_f32 v18, v44
    v_exp_f32 v19, v45
    s_nop 0
    v_add_f32 v15, v15, v18
    v_add_f32 v15, v15, v19
    v_cvt_pk_bf16_f32 v30, v18, v19
    v_exp_f32 v20, v46
    v_exp_f32 v21, v47
    s_nop 0
    v_add_f32 v15, v15, v20
    v_add_f32 v15, v15, v21
    v_cvt_pk_bf16_f32 v31, v20, v21
    s_nop 1
    s_setpc_b64 s[76:77]
.p2align 6
.type L_table,@object
L_table:
    .long 1456, 246, 1456, 0x8006a6
    .long 1456, 246, 1584, 0x8006a6
    .long 2021, 245, 2021, 0x8008da
    .long 2021, 245, 2149, 0x8008da
    .long 964, 256, 964, 0x810444
    .long 1220, 236, 964, 0x810444
    .long 964, 256, 1092, 0x8104c4
    .long 1220, 236, 1092, 0x8104c4
    .long 964, 256, 1220, 0x810544
    .long 1220, 236, 1220, 0x810544
    .long 964, 256, 1348, 0x8105b0
    .long 1220, 236, 1348, 0x8105b0
    .long 1702, 198, 1702, 0x70076c
    .long 1702, 198, 1830, 0x70076c
    .long 516, 224, 516, 0x710284
    .long 740, 224, 516, 0x710284
    .long 516, 224, 644, 0x710304
    .long 740, 224, 644, 0x710304
    .long 516, 224, 772, 0x710364
    .long 740, 224, 772, 0x710364
    .long 516, 224, 868, 0x7103c4
    .long 740, 224, 868, 0x7103c4
    .long 0, 224, 0, 0x710080
    .long 224, 176, 0, 0x710080
    .long 0, 224, 128, 0x7100e0
    .long 224, 176, 128, 0x7100e0
    .long 0, 224, 224, 0x710140
    .long 224, 176, 224, 0x710140
    .long 0, 224, 320, 0x710190
    .long 224, 176, 320, 0x710190
    .long 400, 116, 400, 0x400204
    .long 1900, 121, 1900, 0x4007e5
.size L_table, 512
.section .rodata,"a"
.p2align 6
.amdhsa_kernel standalone__ragged_sequences_packed_sequences__ragged_kernel
  .amdhsa_next_free_vgpr 256
  .amdhsa_next_free_sgpr 96
  .amdhsa_accum_offset 256
  .amdhsa_group_segment_fixed_size 0
  .amdhsa_kernarg_size 56
  .amdhsa_user_sgpr_count 2
  .amdhsa_user_sgpr_kernarg_segment_ptr 1
  .amdhsa_system_sgpr_workgroup_id_x 1
.end_amdhsa_kernel
```
